```python
import torch

def _softmax(x, axis=-1):
    return torch.softmax(x, dim=axis)
def _gelu(x):
    return torch.nn.functional.gelu(x, approximate="tanh")
def _silu(x):
    return torch.nn.functional.silu(x)
def _sigmoid(x):
    return torch.sigmoid(x)
def _layernorm(x, axis=-1, eps=1e-5):
    m = x.mean(dim=axis, keepdim=True)
    v = x.var(dim=axis, keepdim=True, unbiased=False)
    return (x - m) / torch.sqrt(v + eps)
def _scatter_add(tgt, idx, src, axis=0):
    return tgt.clone().index_add_(axis, idx, src)
def _segment_sum(src, seg, n):
    out = torch.zeros((n,) + src.shape[1:], dtype=src.dtype)
    return out.index_add_(0, seg, src)
def _pad(x, pw):
    flat = tuple(v for pair in reversed(pw) for v in pair)
    return torch.nn.functional.pad(x, flat)

kernel_name = 'standalone__channel_attn_eca__vision'

def setup_inputs():

    _w = (lambda a: (lambda t: t.to(torch.bfloat16) if t.is_floating_point() else t)(torch.as_tensor(a)))
    H = W = 224
    C = 192
    k = 3
    return {
        "x": _w((lambda *s: torch.randn(*s, dtype=torch.bfloat16) * 0.4)(1, H, W, C) + (lambda *s: torch.randn(*s, dtype=torch.bfloat16) * 0.4)(1, 1, 1, C) * 2.0),
        "w1d": _w((lambda *s: torch.randn(*s, dtype=torch.bfloat16) * 0.4)(k)),
    }

def reference(x, w1d):
    B, H, W, C = x.shape
    k = 3
    pad = k // 2
    g = torch.einsum("bhwc->bc", x) / (H * W)
    gp = _pad(g, ((0, 0), (pad, pad)))
    s = torch.zeros_like(g)
    for i in range(k):
        s = s + gp[:, i:i + C] * w1d[i]
    s = _sigmoid(s)
    return x * s[:, None, None, :]
```

```asm
; @launch grid=(256,1,1) block=(384,1,1) lds=3136
.amdgcn_target "amdgcn-amd-amdhsa--gfx950"
.text
.globl standalone__channel_attn_eca__vision_kernel
.p2align 12
.p2align 8
.type standalone__channel_attn_eca__vision_kernel,@function
standalone__channel_attn_eca__vision_kernel:
    s_load_dwordx2 s[16:17], s[0:1], 0
    s_mov_b32 s18, 19267584
    s_mov_b32 s19, 0x00020000
    s_mov_b32 s22, s18
    s_mov_b32 s23, s19
    s_mov_b32 s26, 41984
    s_mov_b32 s27, s19
    s_cmpk_ge_u32 s2, 256
    s_cbranch_scc1 L_end
    s_getreg_b32 s4, hwreg(HW_REG_XCC_ID, 0, 3)
    v_lshrrev_b32 v6, 6, v0
    v_mov_b32 v8, 0
    v_readfirstlane_b32 s5, v6
    s_add_u32 s10, s4, 33
    s_lshl_b32 s10, s10, 10
    s_sub_u32 s3, s2, 32
    s_cbranch_scc1 L_lead
    v_bfe_u32 v10, v0, 3, 4
    v_lshrrev_b32 v7, 7, v0
    v_and_b32 v9, 7, v0
    v_mul_u32_u24 v1, 384, v10
    v_lshl_add_u32 v5, v7, 3, v9
    v_lshlrev_b32 v5, 4, v5
    v_add_u32 v1, v1, v5
    v_lshlrev_b32 v11, 1, v0
    s_lshr_b32 s8, s3, 1
    s_xor_b32 s8, s8, s3
    s_and_b32 s8, s8, 4
    s_mul_i32 s8, s8, 3
    s_xor_b32 s6, s8, s3
    s_mulk_i32 s6, 6144
    s_mov_b32 s7, 1376256
    s_mov_b32 s8, s6
    s_waitcnt lgkmcnt(0)
    buffer_load_dwordx4 v[16:19], v1, s[16:19], s8 offen
    s_add_u32 s8, s8, s7
    s_load_dwordx2 s[24:25], s[0:1], 32
    s_load_dwordx2 s[20:21], s[0:1], 16
    s_load_dwordx2 s[28:29], s[0:1], 24
    s_barrier
    buffer_load_dwordx4 v[20:23], v1, s[16:19], s8 offen
    s_add_u32 s8, s8, s7
    s_barrier
    buffer_load_dwordx4 v[24:27], v1, s[16:19], s8 offen
    s_add_u32 s8, s8, s7
    s_barrier
    buffer_load_dwordx4 v[28:31], v1, s[16:19], s8 offen
    s_add_u32 s8, s8, s7
    s_barrier
    s_waitcnt lgkmcnt(0)
    buffer_store_short v8, v11, s[24:27], s10 offen
    buffer_load_dwordx4 v[32:35], v1, s[16:19], s8 offen
    s_add_u32 s8, s8, s7
    s_barrier
    buffer_load_dwordx4 v[36:39], v1, s[16:19], s8 offen
    s_add_u32 s8, s8, s7
    s_barrier
    buffer_load_dwordx4 v[40:43], v1, s[16:19], s8 offen
    s_add_u32 s8, s8, s7
    s_barrier
    buffer_load_dwordx4 v[44:47], v1, s[16:19], s8 offen
    s_add_u32 s8, s8, s7
    s_barrier
    buffer_load_dwordx4 v[48:51], v1, s[16:19], s8 offen
    s_add_u32 s8, s8, s7
    s_barrier
    buffer_load_dwordx4 v[52:55], v1, s[16:19], s8 offen
    s_add_u32 s8, s8, s7
    s_barrier
    buffer_load_dwordx4 v[56:59], v1, s[16:19], s8 offen
    s_add_u32 s8, s8, s7
    s_barrier
    buffer_load_dwordx4 v[60:63], v1, s[16:19], s8 offen
    s_add_u32 s8, s8, s7
    s_barrier
    buffer_load_dwordx4 v[64:67], v1, s[16:19], s8 offen
    s_add_u32 s8, s8, s7
    s_barrier
    buffer_load_dwordx4 v[68:71], v1, s[16:19], s8 offen
    s_branch L_acc
L_lead:
    s_cmp_ge_u32 s5, 4
    s_cbranch_scc1 L_end
    s_load_dwordx2 s[24:25], s[0:1], 32
    s_load_dwordx2 s[28:29], s[0:1], 24
    s_load_dwordx2 s[32:33], s[0:1], 8
    s_lshr_b32 s8, s2, 3
    v_mov_b32 v6, s8
    s_and_b32 s3, s2, 7
    s_cbranch_scc1 L_lead1
    v_lshrrev_b32 v2, 2, v0
    v_and_b32 v3, 3, v0
    v_lshlrev_b32 v3, 4, v3
    v_lshl_add_u32 v2, v2, 7, v3
    v_mov_b32 v9, 0
    v_mov_b32 v10, 0
    v_mov_b32 v11, 0
    v_mov_b32 v12, 1
    s_lshl_b32 s6, s8, 13
    s_lshl_b32 s7, s8, 8
    s_add_u32 s7, s7, 32768
    s_waitcnt lgkmcnt(0)
    buffer_store_dwordx4 v[8:11], v2, s[24:27], s6 offen sc1
    buffer_store_byte v8, v0, s[24:27], s7 offen sc1
    s_cmp_lg_u32 s5, 0
    s_waitcnt vmcnt(0)
    s_barrier
    s_cbranch_scc1 L_lead1
    s_mov_b64 exec, 1
    global_store_byte v6, v12, s[28:29] sc1
    s_mov_b64 exec, -1
L_lead1:
    v_and_b32 v3, 15, v0
    v_and_b32 v5, 48, v0
    v_lshlrev_b32 v4, 2, v3
    v_lshl_add_u32 v2, v5, 3, v4
    s_lshl_b32 s8, s8, 2
    s_add_u32 s8, s8, s5
    s_lshl_b32 s8, s8, 11
    s_lshr_b32 s7, s2, 4
    s_lshl_b32 s7, s7, 2
    s_add_u32 s7, s7, s5
    s_mul_i32 s7, s7, 24
    s_add_i32 s7, s7, -2
    v_add_lshl_u32 v7, s7, v3, 1
    v_bfe_u32 v4, v0, 5, 1
    v_mad_u32_u24 v7, v4, 24, v7
    v_and_b32 v4, 16, v0
    v_mad_u32_u24 v7, v4, 24, v7
    s_waitcnt lgkmcnt(0)
    s_load_dwordx2 s[34:35], s[32:33], 0
    s_add_u32 s40, s24, s8
    s_addc_u32 s41, s25, 0
    s_mov_b32 s44, 0x3ffc3ffc
    s_mov_b32 s45, s44
    s_mov_b32 s12, 0x80018001
    s_mov_b32 s13, s12
    s_mov_b32 s14, 0x41e00000
    s_mov_b32 s30, 131072
    s_cmp_eq_u32 s3, 0
    s_cbranch_scc1 L_lflag_done
L_lflag:
    s_sleep 4
    global_load_ubyte v12, v6, s[28:29] sc1
    s_sub_u32 s30, s30, 1
    s_cbranch_scc1 L_lpoll_done
    s_waitcnt vmcnt(0)
    v_cmp_eq_u32 vcc, 0, v12
    s_cbranch_vccnz L_lflag
L_lflag_done:
    s_waitcnt lgkmcnt(0)
    s_and_b32 s37, s34, 0xffff0000
    v_lshlrev_b32 v10, 16, s34
    v_lshlrev_b32 v11, 16, s35
L_lpoll:
    global_atomic_add_f32 v16, v2, v8, s[40:41] offset:0 sc0 sc1
    global_atomic_add_f32 v17, v2, v8, s[40:41] offset:512 sc0 sc1
    global_atomic_add_f32 v18, v2, v8, s[40:41] offset:1024 sc0 sc1
    global_atomic_add_f32 v19, v2, v8, s[40:41] offset:1536 sc0 sc1
    s_sub_u32 s30, s30, 1
    s_cbranch_scc1 L_lpoll_done
    s_waitcnt vmcnt(0)
    v_min3_f32 v24, v16, v17, v18
    v_min_f32 v24, v24, v19
    v_cmp_gt_f32 vcc, s14, v24
    v_add_f32 v20, v16, v17
    v_add_f32 v22, v18, v19
    s_and_b64 vcc, vcc, s[12:13]
    s_cbranch_scc1 L_lpoll
L_lpoll_done:
    v_permlane32_swap_b32 v20, v22
    v_add_f32 v21, v20, v22
    v_add_f32 v20, v20, v22
    s_nop 1
    v_permlane16_swap_b32 v20, v21
    v_add_f32 v20, v20, v21
    v_cvt_pk_bf16_f32 v8, 0, v20
    v_mul_f32 v8, 0x37a72f05, v8
    v_cvt_pk_bf16_f32 v8, 0, v8
    v_mul_f32 v9, s37, v8
    v_cvt_pk_bf16_f32 v9, 0, v9
    v_mul_f32_dpp v12, v8, v10 row_shr:1 row_mask:0xf bank_mask:0xf bound_ctrl:0
    v_mul_f32_dpp v13, v8, v11 row_shl:1 row_mask:0xf bank_mask:0xf bound_ctrl:0
    v_cvt_pk_bf16_f32 v12, 0, v12
    v_cvt_pk_bf16_f32 v13, 0, v13
    v_add_f32 v8, v12, v9
    v_cvt_pk_bf16_f32 v8, 0, v8
    v_add_f32 v8, v8, v13
    v_cvt_pk_bf16_f32 v8, 0, v8
    v_mul_f32 v8, 0xbfb8aa3b, v8
    v_exp_f32 v8, v8
    s_and_b32 s6, s2, 15
    v_add_f32 v8, 1.0, v8
    v_rcp_f32 v8, v8
    s_mov_b64 exec, s[44:45]
    v_cvt_pk_bf16_f32 v8, v8, v8
    v_or_b32 v8, 0x8000, v8
    buffer_store_short v8, v7, s[24:27], s10 offen
    s_cbranch_scc0 L_lshared
L_end:
    s_endpgm
L_slowflag:
    s_mov_b32 s30, 131072
    v_mov_b32 v13, 0
L_slow1:
    global_load_dword v12, v13, s[28:29] sc1
    s_sub_u32 s30, s30, 1
    s_cbranch_scc1 L_flagok
    s_waitcnt vmcnt(0)
    v_cmp_ne_u32 vcc, 0x01010101, v12
    s_cbranch_vccnz L_slow1
    s_branch L_flagok
L_acc:
    v_and_b32 v6, 9, v10
    v_lshrrev_b32 v9, 2, v6
    v_and_or_b32 v6, v6, 1, v9
    v_mul_u32_u24 v2, 768, v6
    v_lshl_add_u32 v2, v5, 1, v2
    v_and_or_b32 v2, v0, 16, v2
    v_lshlrev_b32 v9, 4, v0
    v_mov_b32 v11, 0x3f80
    v_lshlrev_b32 v9, v9, v11
    s_mov_b32 s32, 0x03030303
    s_mov_b32 s33, s32
    s_lshl_b64 s[34:35], s[32:33], 2
    s_lshl_b64 s[36:37], s[32:33], 4
    s_lshl_b64 s[38:39], s[32:33], 6
    v_cndmask_b32 v12, 0, v9, s[32:33]
    v_cndmask_b32 v13, 0, v9, s[34:35]
    v_cndmask_b32 v14, 0, v9, s[36:37]
    v_cndmask_b32 v15, 0, v9, s[38:39]
    v_lshrrev_b32 v10, 4, v0
    v_add_u32 v9, 4, v0
    v_and_b32 v9, 15, v9
    v_mad_u32_u24 v3, v10, 12, v9
    s_mov_b32 s34, 402659328
    s_mov_b32 s35, s34
    v_add_u32 v7, -2, v3
    v_cmp_lt_u32 vcc, 191, v7
    v_cndmask_b32 v6, 0, 1.0, s[34:35]
    v_lshl_add_u32 v3, v3, 2, 8
    s_or_b64 s[12:13], s[34:35], vcc
    v_and_b32 v7, 8, v10
    v_add_lshl_u32 v7, v7, v10, 10
    v_lshl_add_u32 v4, v9, 2, v7
    s_and_b32 s9, s2, 8
    s_mul_i32 s9, s9, 48
    v_add_u32 v7, s9, v5
    s_lshr_b32 s9, s3, 3
    s_add_u32 s9, s9, s3
    s_and_b32 s9, s9, 7
    s_lshl_b32 s9, s9, 7
    s_add_u32 s8, s9, 8192
    s_waitcnt vmcnt(13)
    v_mfma_f32_16x16x32_bf16 v[8:11], v[12:15], v[16:19], 0
    s_waitcnt vmcnt(12)
    v_mfma_f32_16x16x32_bf16 v[8:11], v[12:15], v[20:23], v[8:11]
    s_waitcnt vmcnt(11)
    v_mfma_f32_16x16x32_bf16 v[8:11], v[12:15], v[24:27], v[8:11]
    s_waitcnt vmcnt(10)
    v_mfma_f32_16x16x32_bf16 v[8:11], v[12:15], v[28:31], v[8:11]
    s_waitcnt vmcnt(9)
    v_mfma_f32_16x16x32_bf16 v[8:11], v[12:15], v[32:35], v[8:11]
    s_waitcnt vmcnt(8)
    v_mfma_f32_16x16x32_bf16 v[8:11], v[12:15], v[36:39], v[8:11]
    s_waitcnt vmcnt(7)
    v_mfma_f32_16x16x32_bf16 v[8:11], v[12:15], v[40:43], v[8:11]
    s_waitcnt vmcnt(6)
    v_mfma_f32_16x16x32_bf16 v[8:11], v[12:15], v[44:47], v[8:11]
    s_waitcnt vmcnt(5)
    v_mfma_f32_16x16x32_bf16 v[8:11], v[12:15], v[48:51], v[8:11]
    s_waitcnt vmcnt(4)
    v_mfma_f32_16x16x32_bf16 v[8:11], v[12:15], v[52:55], v[8:11]
    s_waitcnt vmcnt(3)
    v_mfma_f32_16x16x32_bf16 v[8:11], v[12:15], v[56:59], v[8:11]
    s_waitcnt vmcnt(2)
    s_load_dword s32, s[28:29], 0
    v_mfma_f32_16x16x32_bf16 v[8:11], v[12:15], v[60:63], v[8:11]
    s_waitcnt vmcnt(1)
    v_mfma_f32_16x16x32_bf16 v[8:11], v[12:15], v[64:67], v[8:11]
    s_waitcnt vmcnt(0)
    v_mfma_f32_16x16x32_bf16 v[8:11], v[12:15], v[68:71], v[8:11]
    s_mov_b32 exec_hi, 0
    s_mov_b32 s11, 0xffff0000
    s_cmp_ge_u32 s5, 4
    s_nop 4
    ds_write_b128 v2, v[8:11] offset:16
    s_mov_b32 exec_hi, -1
    s_waitcnt lgkmcnt(0)
    s_barrier
    s_cbranch_scc1 L_noadd
    ds_read2st64_b32 v[8:9], v3 offset0:0 offset1:3
    ds_read2st64_b32 v[10:11], v3 offset0:6 offset1:9
    s_cmp_lg_u32 s32, 0x01010101
    s_cbranch_scc1 L_slowflag
L_flagok:
    s_waitcnt lgkmcnt(1)
    v_add_f32 v2, v8, v9
    s_waitcnt lgkmcnt(0)
    v_add_f32 v10, v10, v11
    v_add_f32 v2, v2, v10
    v_cndmask_b32 v6, v2, v6, s[12:13]
    buffer_atomic_add_f32 v6, v4, s[24:27], s9 offen sc1
    buffer_atomic_add_f32 v6, v4, s[24:27], s8 offen sc1
L_noadd:
    v_lshlrev_b32 v72, 16, v16
    v_and_b32 v16, s11, v16
    v_lshlrev_b32 v73, 16, v17
    v_and_b32 v17, s11, v17
    v_lshlrev_b32 v74, 16, v18
    v_and_b32 v18, s11, v18
    v_lshlrev_b32 v75, 16, v19
    v_and_b32 v19, s11, v19
    v_lshlrev_b32 v76, 16, v20
    v_and_b32 v20, s11, v20
    v_lshlrev_b32 v77, 16, v21
    v_and_b32 v21, s11, v21
    v_lshlrev_b32 v78, 16, v22
    v_and_b32 v22, s11, v22
    v_lshlrev_b32 v79, 16, v23
    v_and_b32 v23, s11, v23
    v_lshlrev_b32 v80, 16, v24
    v_and_b32 v24, s11, v24
    v_lshlrev_b32 v81, 16, v25
    v_and_b32 v25, s11, v25
    v_lshlrev_b32 v82, 16, v26
    v_and_b32 v26, s11, v26
    v_lshlrev_b32 v83, 16, v27
    v_and_b32 v27, s11, v27
    v_lshlrev_b32 v84, 16, v28
    v_and_b32 v28, s11, v28
    v_lshlrev_b32 v85, 16, v29
    v_and_b32 v29, s11, v29
    v_lshlrev_b32 v86, 16, v30
    v_and_b32 v30, s11, v30
    v_lshlrev_b32 v87, 16, v31
    v_and_b32 v31, s11, v31
    v_lshlrev_b32 v88, 16, v32
    v_and_b32 v32, s11, v32
    v_lshlrev_b32 v89, 16, v33
    v_and_b32 v33, s11, v33
    v_lshlrev_b32 v90, 16, v34
    v_and_b32 v34, s11, v34
    v_lshlrev_b32 v91, 16, v35
    v_and_b32 v35, s11, v35
    v_lshlrev_b32 v92, 16, v36
    v_and_b32 v36, s11, v36
    v_lshlrev_b32 v93, 16, v37
    v_and_b32 v37, s11, v37
    v_lshlrev_b32 v94, 16, v38
    v_and_b32 v38, s11, v38
    v_lshlrev_b32 v95, 16, v39
    v_and_b32 v39, s11, v39
    v_lshlrev_b32 v96, 16, v40
    v_and_b32 v40, s11, v40
    v_lshlrev_b32 v97, 16, v41
    v_and_b32 v41, s11, v41
    v_lshlrev_b32 v98, 16, v42
    v_and_b32 v42, s11, v42
    v_lshlrev_b32 v99, 16, v43
    v_and_b32 v43, s11, v43
    v_lshlrev_b32 v100, 16, v44
    v_and_b32 v44, s11, v44
    v_lshlrev_b32 v101, 16, v45
    v_and_b32 v45, s11, v45
    v_lshlrev_b32 v102, 16, v46
    v_and_b32 v46, s11, v46
    v_lshlrev_b32 v103, 16, v47
    v_and_b32 v47, s11, v47
    v_lshlrev_b32 v104, 16, v48
    v_and_b32 v48, s11, v48
    v_lshlrev_b32 v105, 16, v49
    v_and_b32 v49, s11, v49
    v_lshlrev_b32 v106, 16, v50
    v_and_b32 v50, s11, v50
    v_lshlrev_b32 v107, 16, v51
    v_and_b32 v51, s11, v51
    v_lshlrev_b32 v108, 16, v52
    v_and_b32 v52, s11, v52
    v_lshlrev_b32 v109, 16, v53
    v_and_b32 v53, s11, v53
    v_lshlrev_b32 v110, 16, v54
    v_and_b32 v54, s11, v54
    v_lshlrev_b32 v111, 16, v55
    v_and_b32 v55, s11, v55
    v_lshlrev_b32 v112, 16, v56
    v_and_b32 v56, s11, v56
    v_lshlrev_b32 v113, 16, v57
    v_and_b32 v57, s11, v57
    v_lshlrev_b32 v114, 16, v58
    v_and_b32 v58, s11, v58
    v_lshlrev_b32 v115, 16, v59
    v_and_b32 v59, s11, v59
    v_lshlrev_b32 v116, 16, v60
    v_and_b32 v60, s11, v60
    v_lshlrev_b32 v117, 16, v61
    v_and_b32 v61, s11, v61
    v_lshlrev_b32 v118, 16, v62
    v_and_b32 v62, s11, v62
    v_lshlrev_b32 v119, 16, v63
    v_and_b32 v63, s11, v63
    v_lshlrev_b32 v120, 16, v64
    v_and_b32 v64, s11, v64
    v_lshlrev_b32 v121, 16, v65
    v_and_b32 v65, s11, v65
    v_lshlrev_b32 v122, 16, v66
    v_and_b32 v66, s11, v66
    v_lshlrev_b32 v123, 16, v67
    v_and_b32 v67, s11, v67
    v_lshlrev_b32 v124, 16, v68
    v_and_b32 v68, s11, v68
    v_lshlrev_b32 v125, 16, v69
    v_and_b32 v69, s11, v69
    v_lshlrev_b32 v126, 16, v70
    v_and_b32 v70, s11, v70
    v_lshlrev_b32 v127, 16, v71
    v_and_b32 v71, s11, v71
    s_mov_b32 s15, 0x80008000
    s_movk_i32 s30, 256
L_poll:
    buffer_load_dwordx4 v[12:15], v7, s[24:27], s10 offen sc1
    s_sub_u32 s30, s30, 1
    s_cbranch_scc1 L_pollslow
    s_waitcnt vmcnt(0)
    v_bitop3_b32 v8, v12, v13, v14 bitop3:0x80
    v_bitop3_b32 v8, v8, v15, s15 bitop3:0x80
    v_cmp_ne_u32 vcc, s15, v8
    s_cbranch_vccnz L_poll
L_polldone:
    v_lshlrev_b32 v8, 16, v12
    v_and_b32 v12, s11, v12
    v_lshlrev_b32 v9, 16, v13
    v_and_b32 v13, s11, v13
    v_lshlrev_b32 v10, 16, v14
    v_and_b32 v14, s11, v14
    v_lshlrev_b32 v11, 16, v15
    v_and_b32 v15, s11, v15
    v_pk_mul_f32 v[72:73], v[72:73], v[8:9] neg_lo:[0,1] neg_hi:[0,1]
    v_pk_mul_f32 v[16:17], v[16:17], v[12:13] neg_lo:[0,1] neg_hi:[0,1]
    v_pk_mul_f32 v[74:75], v[74:75], v[10:11] neg_lo:[0,1] neg_hi:[0,1]
    v_pk_mul_f32 v[18:19], v[18:19], v[14:15] neg_lo:[0,1] neg_hi:[0,1]
    v_cvt_pk_bf16_f32 v16, v72, v16
    v_cvt_pk_bf16_f32 v17, v73, v17
    v_cvt_pk_bf16_f32 v18, v74, v18
    v_cvt_pk_bf16_f32 v19, v75, v19
    buffer_store_dwordx4 v[16:19], v1, s[20:23], s6 offen nt
    s_add_u32 s6, s6, s7
    v_pk_mul_f32 v[76:77], v[76:77], v[8:9] neg_lo:[0,1] neg_hi:[0,1]
    v_pk_mul_f32 v[20:21], v[20:21], v[12:13] neg_lo:[0,1] neg_hi:[0,1]
    v_pk_mul_f32 v[78:79], v[78:79], v[10:11] neg_lo:[0,1] neg_hi:[0,1]
    v_pk_mul_f32 v[22:23], v[22:23], v[14:15] neg_lo:[0,1] neg_hi:[0,1]
    v_cvt_pk_bf16_f32 v20, v76, v20
    v_cvt_pk_bf16_f32 v21, v77, v21
    v_cvt_pk_bf16_f32 v22, v78, v22
    v_cvt_pk_bf16_f32 v23, v79, v23
    buffer_store_dwordx4 v[20:23], v1, s[20:23], s6 offen nt
    s_add_u32 s6, s6, s7
    v_pk_mul_f32 v[80:81], v[80:81], v[8:9] neg_lo:[0,1] neg_hi:[0,1]
    v_pk_mul_f32 v[24:25], v[24:25], v[12:13] neg_lo:[0,1] neg_hi:[0,1]
    v_pk_mul_f32 v[82:83], v[82:83], v[10:11] neg_lo:[0,1] neg_hi:[0,1]
    v_pk_mul_f32 v[26:27], v[26:27], v[14:15] neg_lo:[0,1] neg_hi:[0,1]
    v_cvt_pk_bf16_f32 v24, v80, v24
    v_cvt_pk_bf16_f32 v25, v81, v25
    v_cvt_pk_bf16_f32 v26, v82, v26
    v_cvt_pk_bf16_f32 v27, v83, v27
    s_barrier
    buffer_store_dwordx4 v[24:27], v1, s[20:23], s6 offen nt
    s_add_u32 s6, s6, s7
    v_pk_mul_f32 v[84:85], v[84:85], v[8:9] neg_lo:[0,1] neg_hi:[0,1]
    v_pk_mul_f32 v[28:29], v[28:29], v[12:13] neg_lo:[0,1] neg_hi:[0,1]
    v_pk_mul_f32 v[86:87], v[86:87], v[10:11] neg_lo:[0,1] neg_hi:[0,1]
    v_pk_mul_f32 v[30:31], v[30:31], v[14:15] neg_lo:[0,1] neg_hi:[0,1]
    v_cvt_pk_bf16_f32 v28, v84, v28
    v_cvt_pk_bf16_f32 v29, v85, v29
    v_cvt_pk_bf16_f32 v30, v86, v30
    v_cvt_pk_bf16_f32 v31, v87, v31
    s_barrier
    buffer_store_dwordx4 v[28:31], v1, s[20:23], s6 offen nt
    s_add_u32 s6, s6, s7
    v_pk_mul_f32 v[88:89], v[88:89], v[8:9] neg_lo:[0,1] neg_hi:[0,1]
    v_pk_mul_f32 v[32:33], v[32:33], v[12:13] neg_lo:[0,1] neg_hi:[0,1]
    v_pk_mul_f32 v[90:91], v[90:91], v[10:11] neg_lo:[0,1] neg_hi:[0,1]
    v_pk_mul_f32 v[34:35], v[34:35], v[14:15] neg_lo:[0,1] neg_hi:[0,1]
    v_cvt_pk_bf16_f32 v32, v88, v32
    v_cvt_pk_bf16_f32 v33, v89, v33
    v_cvt_pk_bf16_f32 v34, v90, v34
    v_cvt_pk_bf16_f32 v35, v91, v35
    s_barrier
    buffer_store_dwordx4 v[32:35], v1, s[20:23], s6 offen
    s_add_u32 s6, s6, s7
    v_pk_mul_f32 v[92:93], v[92:93], v[8:9] neg_lo:[0,1] neg_hi:[0,1]
    v_pk_mul_f32 v[36:37], v[36:37], v[12:13] neg_lo:[0,1] neg_hi:[0,1]
    v_pk_mul_f32 v[94:95], v[94:95], v[10:11] neg_lo:[0,1] neg_hi:[0,1]
    v_pk_mul_f32 v[38:39], v[38:39], v[14:15] neg_lo:[0,1] neg_hi:[0,1]
    v_cvt_pk_bf16_f32 v36, v92, v36
    v_cvt_pk_bf16_f32 v37, v93, v37
    v_cvt_pk_bf16_f32 v38, v94, v38
    v_cvt_pk_bf16_f32 v39, v95, v39
    s_barrier
    buffer_store_dwordx4 v[36:39], v1, s[20:23], s6 offen nt
    s_add_u32 s6, s6, s7
    v_pk_mul_f32 v[96:97], v[96:97], v[8:9] neg_lo:[0,1] neg_hi:[0,1]
    v_pk_mul_f32 v[40:41], v[40:41], v[12:13] neg_lo:[0,1] neg_hi:[0,1]
    v_pk_mul_f32 v[98:99], v[98:99], v[10:11] neg_lo:[0,1] neg_hi:[0,1]
    v_pk_mul_f32 v[42:43], v[42:43], v[14:15] neg_lo:[0,1] neg_hi:[0,1]
    v_cvt_pk_bf16_f32 v40, v96, v40
    v_cvt_pk_bf16_f32 v41, v97, v41
    v_cvt_pk_bf16_f32 v42, v98, v42
    v_cvt_pk_bf16_f32 v43, v99, v43
    s_barrier
    buffer_store_dwordx4 v[40:43], v1, s[20:23], s6 offen nt
    s_add_u32 s6, s6, s7
    v_pk_mul_f32 v[100:101], v[100:101], v[8:9] neg_lo:[0,1] neg_hi:[0,1]
    v_pk_mul_f32 v[44:45], v[44:45], v[12:13] neg_lo:[0,1] neg_hi:[0,1]
    v_pk_mul_f32 v[102:103], v[102:103], v[10:11] neg_lo:[0,1] neg_hi:[0,1]
    v_pk_mul_f32 v[46:47], v[46:47], v[14:15] neg_lo:[0,1] neg_hi:[0,1]
    v_cvt_pk_bf16_f32 v44, v100, v44
    v_cvt_pk_bf16_f32 v45, v101, v45
    v_cvt_pk_bf16_f32 v46, v102, v46
    v_cvt_pk_bf16_f32 v47, v103, v47
    s_barrier
    buffer_store_dwordx4 v[44:47], v1, s[20:23], s6 offen nt
    s_add_u32 s6, s6, s7
    v_pk_mul_f32 v[104:105], v[104:105], v[8:9] neg_lo:[0,1] neg_hi:[0,1]
    v_pk_mul_f32 v[48:49], v[48:49], v[12:13] neg_lo:[0,1] neg_hi:[0,1]
    v_pk_mul_f32 v[106:107], v[106:107], v[10:11] neg_lo:[0,1] neg_hi:[0,1]
    v_pk_mul_f32 v[50:51], v[50:51], v[14:15] neg_lo:[0,1] neg_hi:[0,1]
    v_cvt_pk_bf16_f32 v48, v104, v48
    v_cvt_pk_bf16_f32 v49, v105, v49
    v_cvt_pk_bf16_f32 v50, v106, v50
    v_cvt_pk_bf16_f32 v51, v107, v51
    s_barrier
    buffer_store_dwordx4 v[48:51], v1, s[20:23], s6 offen nt
    s_add_u32 s6, s6, s7
    v_pk_mul_f32 v[108:109], v[108:109], v[8:9] neg_lo:[0,1] neg_hi:[0,1]
    v_pk_mul_f32 v[52:53], v[52:53], v[12:13] neg_lo:[0,1] neg_hi:[0,1]
    v_pk_mul_f32 v[110:111], v[110:111], v[10:11] neg_lo:[0,1] neg_hi:[0,1]
    v_pk_mul_f32 v[54:55], v[54:55], v[14:15] neg_lo:[0,1] neg_hi:[0,1]
    v_cvt_pk_bf16_f32 v52, v108, v52
    v_cvt_pk_bf16_f32 v53, v109, v53
    v_cvt_pk_bf16_f32 v54, v110, v54
    v_cvt_pk_bf16_f32 v55, v111, v55
    s_barrier
    buffer_store_dwordx4 v[52:55], v1, s[20:23], s6 offen
    s_add_u32 s6, s6, s7
    v_pk_mul_f32 v[112:113], v[112:113], v[8:9] neg_lo:[0,1] neg_hi:[0,1]
    v_pk_mul_f32 v[56:57], v[56:57], v[12:13] neg_lo:[0,1] neg_hi:[0,1]
    v_pk_mul_f32 v[114:115], v[114:115], v[10:11] neg_lo:[0,1] neg_hi:[0,1]
    v_pk_mul_f32 v[58:59], v[58:59], v[14:15] neg_lo:[0,1] neg_hi:[0,1]
    v_cvt_pk_bf16_f32 v56, v112, v56
    v_cvt_pk_bf16_f32 v57, v113, v57
    v_cvt_pk_bf16_f32 v58, v114, v58
    v_cvt_pk_bf16_f32 v59, v115, v59
    s_barrier
    buffer_store_dwordx4 v[56:59], v1, s[20:23], s6 offen nt
    s_add_u32 s6, s6, s7
    v_pk_mul_f32 v[116:117], v[116:117], v[8:9] neg_lo:[0,1] neg_hi:[0,1]
    v_pk_mul_f32 v[60:61], v[60:61], v[12:13] neg_lo:[0,1] neg_hi:[0,1]
    v_pk_mul_f32 v[118:119], v[118:119], v[10:11] neg_lo:[0,1] neg_hi:[0,1]
    v_pk_mul_f32 v[62:63], v[62:63], v[14:15] neg_lo:[0,1] neg_hi:[0,1]
    v_cvt_pk_bf16_f32 v60, v116, v60
    v_cvt_pk_bf16_f32 v61, v117, v61
    v_cvt_pk_bf16_f32 v62, v118, v62
    v_cvt_pk_bf16_f32 v63, v119, v63
    s_barrier
    buffer_store_dwordx4 v[60:63], v1, s[20:23], s6 offen nt
    s_add_u32 s6, s6, s7
    v_pk_mul_f32 v[120:121], v[120:121], v[8:9] neg_lo:[0,1] neg_hi:[0,1]
    v_pk_mul_f32 v[64:65], v[64:65], v[12:13] neg_lo:[0,1] neg_hi:[0,1]
    v_pk_mul_f32 v[122:123], v[122:123], v[10:11] neg_lo:[0,1] neg_hi:[0,1]
    v_pk_mul_f32 v[66:67], v[66:67], v[14:15] neg_lo:[0,1] neg_hi:[0,1]
    v_cvt_pk_bf16_f32 v64, v120, v64
    v_cvt_pk_bf16_f32 v65, v121, v65
    v_cvt_pk_bf16_f32 v66, v122, v66
    v_cvt_pk_bf16_f32 v67, v123, v67
    s_barrier
    buffer_store_dwordx4 v[64:67], v1, s[20:23], s6 offen nt
    s_add_u32 s6, s6, s7
    v_pk_mul_f32 v[124:125], v[124:125], v[8:9] neg_lo:[0,1] neg_hi:[0,1]
    v_pk_mul_f32 v[68:69], v[68:69], v[12:13] neg_lo:[0,1] neg_hi:[0,1]
    v_pk_mul_f32 v[126:127], v[126:127], v[10:11] neg_lo:[0,1] neg_hi:[0,1]
    v_pk_mul_f32 v[70:71], v[70:71], v[14:15] neg_lo:[0,1] neg_hi:[0,1]
    v_cvt_pk_bf16_f32 v68, v124, v68
    v_cvt_pk_bf16_f32 v69, v125, v69
    v_cvt_pk_bf16_f32 v70, v126, v70
    v_cvt_pk_bf16_f32 v71, v127, v71
    s_barrier
    buffer_store_dwordx4 v[68:71], v1, s[20:23], s6 offen
    s_endpgm
L_lshared:
    s_mov_b32 s8, 32768
    buffer_store_short v8, v7, s[24:27], s8 offen sc1
    s_endpgm
L_pollslow:
    s_cmp_eq_u32 s10, 32768
    s_cbranch_scc1 L_polldone
    s_mov_b32 s30, 131072
    v_mov_b32 v10, 0
L_slow2:
    global_load_dword v12, v10, s[28:29] sc1
    s_sub_u32 s30, s30, 1
    s_cbranch_scc1 L_slow3
    s_waitcnt vmcnt(0)
    v_cmp_ne_u32 vcc, 0x01010101, v12
    s_cbranch_vccnz L_slow2
L_slow3:
    s_mov_b32 s10, 32768
    s_mov_b32 s30, 131072
    s_branch L_poll
.section .rodata,"a"
.p2align 6
.amdhsa_kernel standalone__channel_attn_eca__vision_kernel
  .amdhsa_next_free_vgpr 128
  .amdhsa_next_free_sgpr 50
  .amdhsa_accum_offset 128
  .amdhsa_group_segment_fixed_size 0
  .amdhsa_kernarg_size 40
  .amdhsa_user_sgpr_count 2
  .amdhsa_user_sgpr_kernarg_segment_ptr 1
  .amdhsa_system_sgpr_workgroup_id_x 1
  .amdhsa_float_denorm_mode_32 3
.end_amdhsa_kernel
```
